```python
import torch

def _softmax(x, axis=-1):
    return torch.softmax(x, dim=axis)
def _gelu(x):
    return torch.nn.functional.gelu(x, approximate="tanh")
def _silu(x):
    return torch.nn.functional.silu(x)
def _sigmoid(x):
    return torch.sigmoid(x)
def _layernorm(x, axis=-1, eps=1e-5):
    m = x.mean(dim=axis, keepdim=True)
    v = x.var(dim=axis, keepdim=True, unbiased=False)
    return (x - m) / torch.sqrt(v + eps)
def _scatter_add(tgt, idx, src, axis=0):
    return tgt.clone().index_add_(axis, idx, src)
def _segment_sum(src, seg, n):
    out = torch.zeros((n,) + src.shape[1:], dtype=src.dtype)
    return out.index_add_(0, seg, src)
def _pad(x, pw):
    flat = tuple(v for pair in reversed(pw) for v in pair)
    return torch.nn.functional.pad(x, flat)

kernel_name = 'standalone__sliding_block_cached__sampling'

def setup_inputs():

    _w = (lambda a: (lambda t: t.to(torch.bfloat16) if t.is_floating_point() else t)(torch.as_tensor(a)))
    B, Sq, D = 16, 1, 512
    Hq, Hkv, Sk, Dh = 32, 8, 4096, 128
    assert Hq % Hkv == 0, (Hq, Hkv)
    return {
        "x": _w((lambda *s: torch.randn(*s, dtype=torch.bfloat16) * 0.8)(B, Sq, D)),
        "k_cache": _w((lambda *s: torch.randn(*s, dtype=torch.bfloat16) * 0.8)(B, Hkv, Sk, Dh)),
        "v_cache": _w((lambda *s: torch.randn(*s, dtype=torch.bfloat16) * 0.05)(B, Hkv, Sk, Dh)),
        "wq": _w((lambda *s: torch.randn(*s, dtype=torch.bfloat16) * 0.8)(D, Hq * Dh) * (D ** -0.5)),
        "wo": _w((lambda *s: torch.randn(*s, dtype=torch.bfloat16) * 0.05)(Hq * Dh, D) * ((Hq * Dh) ** -0.5)),
    }

def reference(x, k_cache, v_cache, wq, wo):
    B, Sq, D = x.shape
    Hq, Dh = 32, 128
    Hkv, Sk = k_cache.shape[1], k_cache.shape[2]
    W = min(4096, max(256, Sk // 4))
    rep = Hq // Hkv
    q = (lambda x, *d: x.permute(*d))((x @ wq).reshape(B, Sq, Hq, Dh), 0, 2, 1, 3)
    k = (lambda x, n, axis: torch.repeat_interleave(x, n, dim=axis))(k_cache[:, :, Sk - W:, :], rep, axis=1)
    v = (lambda x, n, axis: torch.repeat_interleave(x, n, dim=axis))(v_cache[:, :, Sk - W:, :], rep, axis=1)
    scores = torch.einsum("bhqd,bhkd->bhqk", q, k) * (Dh ** -0.5)
    p = _softmax(scores, axis=-1)
    o = torch.einsum("bhqk,bhkd->bhqd", p, v)
    return (lambda x, *d: x.permute(*d))(o, 0, 2, 1, 3).reshape(B, Sq, Hq * Dh) @ wo
```

```asm
; @launch grid=(256,1,1) block=(640,1,1) lds=51200
.amdgcn_target "amdgcn-amd-amdhsa--gfx950"
.text
.p2align 12
.fill 128, 4, 0xbf810000
.globl standalone__sliding_block_cached__sampling_kernel
.p2align 8
.type standalone__sliding_block_cached__sampling_kernel,@function
standalone__sliding_block_cached__sampling_kernel:
    s_load_dwordx16 s[4:19], s[0:1], 0
    v_lshrrev_b32 v1, 6, v0
    v_and_b32 v0, 63, v0
    s_cmp_ge_u32 s2, 256
    s_cbranch_scc1 L_end
    v_readfirstlane_b32 s3, v1
    s_and_b32 s20, s2, 7
    s_lshr_b32 s21, s2, 3
    s_cmp_lg_u32 s3, 0
    s_cbranch_scc1 L_notcomm
    s_and_b32 s23, s21, 3
    s_cbranch_scc1 L_nocpf
    s_getpc_b64 s[40:41]
L_cpf:
    v_lshlrev_b32 v165, 7, v0
    v_min_u32 v165, L_end-L_cpf-704, v165
    global_load_dword v164, v165, s[40:41] offset:704
L_nocpf:
    s_setprio 3
    s_lshr_b32 s22, s21, 3
    s_and_b32 s23, s21, 7
    s_lshl_b32 s25, s22, 20
    s_lshl_b32 s26, s20, 10
    s_add_u32 s25, s25, s26
    s_lshl_b32 s26, s23, 7
    s_add_u32 s25, s25, s26
    v_lshrrev_b32 v2, 3, v0
    v_and_b32 v3, 7, v0
    v_lshlrev_b32 v100, 13, v2
    v_lshl_add_u32 v100, v3, 4, v100
    v_add_u32 v100, s25, v100
    s_mov_b32 s26, 65536
    v_add_u32 v101, s26, v100
    v_add_u32 v102, s26, v101
    v_add_u32 v103, s26, v102
    v_add_u32 v104, s26, v103
    v_add_u32 v105, s26, v104
    v_add_u32 v106, s26, v105
    v_add_u32 v107, s26, v106
    v_add_u32 v108, s26, v107
    v_add_u32 v109, s26, v108
    v_add_u32 v110, s26, v109
    v_add_u32 v111, s26, v110
    v_add_u32 v112, s26, v111
    v_add_u32 v113, s26, v112
    v_add_u32 v114, s26, v113
    v_add_u32 v115, s26, v114
    v_and_b32 v6, 15, v0
    v_lshrrev_b32 v7, 4, v0
    s_lshl_b32 s25, s22, 8
    v_lshlrev_b32 v4, 10, v6
    v_lshl_add_u32 v4, v7, 4, v4
    v_add_u32 v4, s25, v4
    s_waitcnt lgkmcnt(0)
    s_load_dword s30, s[18:19], 0
    global_load_dwordx4 v[32:35], v100, s[10:11] nt
    global_load_dwordx4 v[36:39], v101, s[10:11] nt
    global_load_dwordx4 v[40:43], v102, s[10:11] nt
    global_load_dwordx4 v[44:47], v103, s[10:11] nt
    global_load_dwordx4 v[48:51], v104, s[10:11] nt
    global_load_dwordx4 v[52:55], v105, s[10:11] nt
    global_load_dwordx4 v[56:59], v106, s[10:11] nt
    global_load_dwordx4 v[60:63], v107, s[10:11] nt
    global_load_dwordx4 v[64:67], v108, s[10:11] nt
    global_load_dwordx4 v[68:71], v109, s[10:11] nt
    global_load_dwordx4 v[72:75], v110, s[10:11] nt
    global_load_dwordx4 v[76:79], v111, s[10:11] nt
    global_load_dwordx4 v[80:83], v112, s[10:11] nt
    global_load_dwordx4 v[84:87], v113, s[10:11] nt
    global_load_dwordx4 v[88:91], v114, s[10:11] nt
    global_load_dwordx4 v[92:95], v115, s[10:11] nt
    s_barrier
    global_load_dwordx4 v[116:119], v4, s[4:5] offset:0
    global_load_dwordx4 v[120:123], v4, s[4:5] offset:64
    global_load_dwordx4 v[124:127], v4, s[4:5] offset:128
    global_load_dwordx4 v[128:131], v4, s[4:5] offset:192
    s_branch L_comm2
L_notcomm:
    s_cmp_eq_u32 s3, 9
    s_cbranch_scc1 L_w9
    v_mov_b32 v8, 0
    v_mov_b32 v9, 0
    v_mov_b32 v10, 0
    v_mov_b32 v11, 0
    v_lshlrev_b32 v160, 4, v0
    ds_write_b128 v160, v[8:11]
    s_lshr_b32 s22, s21, 1
    s_lshl_b32 s22, s22, 3
    s_add_u32 s22, s22, s20
    s_lshl_b32 s22, s22, 20
    s_and_b32 s23, s21, 1
    s_lshl_b32 s23, s23, 12
    s_add_u32 s22, s22, s23
    s_lshl_b32 s23, s3, 15
    s_add_u32 s22, s22, s23
    s_add_u32 s22, s22, 753664
    s_lshr_b32 s23, s21, 1
    s_xor_b32 s23, s23, s20
    s_and_b32 s23, s23, 3
    s_lshl_b32 s23, s23, 13
    s_add_u32 s22, s22, s23
    s_movk_i32 s23, 12288
    s_movk_i32 s25, 20480
    v_lshlrev_b32 v6, 6, v0
    v_and_b32 v6, 0x300, v6
    v_lshlrev_b32 v7, 2, v0
    v_and_b32 v7, 0xc0, v7
    v_and_b32 v1, 3, v0
    v_lshl_add_u32 v6, v1, 4, v6
    v_add3_u32 v2, v6, v7, s22
    v_xor_b32 v3, s23, v2
    v_xor_b32 v4, s25, v2
    v_xor_b32 v5, s23, v4
    v_add_u32 v160, s22, v160
    v_xor_b32 v161, s23, v160
    v_xor_b32 v162, s25, v160
    v_xor_b32 v163, s23, v162
    v_mov_b32 v6, 0
    s_sub_u32 s24, s3, 1
    s_cmp_le_u32 s3, 1
    s_waitcnt lgkmcnt(0)
    s_barrier
    s_cbranch_scc1 L_kgo
L_kwait:
    ds_read_b32 v7, v6
    s_waitcnt lgkmcnt(0)
    v_cmp_gt_u32 vcc, s24, v7
    s_cbranch_vccz L_kgo
    s_sleep 1
    s_branch L_kwait
L_kgo:
    v_mov_b32 v7, s3
    global_load_dwordx4 v[32:35], v2, s[6:7] offset:0 nt
    global_load_dwordx4 v[36:39], v2, s[6:7] offset:1024 nt
    s_nop 0
    global_load_dwordx4 v[40:43], v2, s[6:7] offset:2048 nt
    global_load_dwordx4 v[44:47], v2, s[6:7] offset:3072 nt
    s_nop 0
    global_load_dwordx4 v[48:51], v3, s[6:7] offset:0 nt
    global_load_dwordx4 v[52:55], v3, s[6:7] offset:1024 nt
    s_nop 0
    global_load_dwordx4 v[56:59], v3, s[6:7] offset:2048 nt
    global_load_dwordx4 v[60:63], v3, s[6:7] offset:3072 nt
    s_nop 0
    global_load_dwordx4 v[64:67], v4, s[6:7] offset:0 nt
    global_load_dwordx4 v[68:71], v4, s[6:7] offset:1024 nt
    s_nop 0
    global_load_dwordx4 v[72:75], v4, s[6:7] offset:2048 nt
    global_load_dwordx4 v[76:79], v4, s[6:7] offset:3072 nt
    s_nop 0
    global_load_dwordx4 v[80:83], v5, s[6:7] offset:0 nt
    global_load_dwordx4 v[84:87], v5, s[6:7] offset:1024 nt
    s_nop 0
    global_load_dwordx4 v[88:91], v5, s[6:7] offset:2048 nt
    global_load_dwordx4 v[92:95], v5, s[6:7] offset:3072 nt
    ds_max_u32 v6, v7
    s_branch L_afterw9
L_w9:
    s_setprio 3
    s_lshl_b32 s27, s20, 5
    s_add_u32 s27, s27, s21
    s_lshl_b32 s25, s20, 5
    s_add_u32 s25, s25, s21
    s_lshl_b32 s25, s25, 10
    s_add_u32 s25, s25, 262144
    v_lshlrev_b32 v1, 4, v0
    v_add_u32 v2, s25, v1
    s_lshl_b32 s25, s20, 5
    s_add_u32 s25, s25, s21
    s_mul_i32 s25, s25, 256
    s_add_u32 s25, s25, 524288
    v_add_u32 v5, s25, v1
    v_mov_b32 v8, -1
    v_mov_b32 v9, -1
    v_mov_b32 v10, -1
    v_mov_b32 v11, -1
    v_mov_b32 v12, 0
    v_mov_b32 v13, 0
    v_mov_b32 v14, 0
    v_mov_b32 v15, 0
    s_and_b32 s25, s21, 2
    s_waitcnt lgkmcnt(0)
    s_load_dword s30, s[18:19], 0
    global_store_dwordx4 v2, v[8:11], s[18:19] sc1
    s_cbranch_scc1 L_nomclr
    s_mov_b64 exec, 0xff
    global_store_dwordx4 v5, v[12:15], s[18:19] sc1
    s_mov_b64 exec, -1
L_nomclr:
    s_barrier
    s_branch L_tail
L_afterw9:
    s_add_u32 s29, s3, 7
    s_cmp_gt_u32 s3, 4
    s_cbranch_scc1 L_late
L_vwaita:
    ds_read_b32 v7, v6
    s_waitcnt lgkmcnt(0)
    v_cmp_gt_u32 vcc, s29, v7
    s_cbranch_vccz L_vgoa
    s_sleep 1
    s_branch L_vwaita
L_vgoa:
    v_add_u32 v7, 1, v7
    global_load_dwordx4 v[96:99], v160, s[8:9] offset:0 nt
    global_load_dwordx4 v[100:103], v160, s[8:9] offset:1024 nt
    s_nop 0
    global_load_dwordx4 v[104:107], v160, s[8:9] offset:2048 nt
    global_load_dwordx4 v[108:111], v160, s[8:9] offset:3072 nt
    s_nop 0
    global_load_dwordx4 v[112:115], v161, s[8:9] offset:0 nt
    global_load_dwordx4 v[116:119], v161, s[8:9] offset:1024 nt
    s_nop 0
    global_load_dwordx4 v[120:123], v161, s[8:9] offset:2048 nt
    global_load_dwordx4 v[124:127], v161, s[8:9] offset:3072 nt
    s_nop 0
    global_load_dwordx4 v[128:131], v162, s[8:9] offset:0 nt
    global_load_dwordx4 v[132:135], v162, s[8:9] offset:1024 nt
    s_nop 0
    global_load_dwordx4 v[136:139], v162, s[8:9] offset:2048 nt
    global_load_dwordx4 v[140:143], v162, s[8:9] offset:3072 nt
    s_nop 0
    global_load_dwordx4 v[144:147], v163, s[8:9] offset:0 nt
    global_load_dwordx4 v[148:151], v163, s[8:9] offset:1024 nt
    s_nop 0
    global_load_dwordx4 v[152:155], v163, s[8:9] offset:2048 nt
    global_load_dwordx4 v[156:159], v163, s[8:9] offset:3072 nt
    ds_write_b32 v6, v7
    s_waitcnt vmcnt(16)
    s_branch L_consts
L_late:
    s_waitcnt vmcnt(0)
L_consts:
    v_and_b32 v1, 3, v0
    v_lshlrev_b32 v2, 8, v1
    v_lshrrev_b32 v3, 2, v0
    v_lshl_add_u32 v2, v3, 4, v2
    v_bfe_u32 v3, v0, 2, 2
    v_cmp_eq_u32 vcc, 0, v3
    v_cmp_eq_u32 s[26:27], 1, v3
    v_cmp_eq_u32 s[32:33], 2, v3
    v_cmp_eq_u32 s[30:31], 3, v3
    v_cndmask_b32 v16, 0, -1, vcc
    v_cndmask_b32 v17, 0, -1, s[26:27]
    v_cndmask_b32 v18, 0, -1, s[32:33]
    v_cndmask_b32 v19, 0, -1, s[30:31]
    s_mov_b32 s25, 1069066811
    s_mov_b32 s26, 0x05040100
    s_mov_b32 s27, 0x07060302
L_qwait:
    ds_read_b32 v7, v6 offset:16
    ds_read_b128 v[8:11], v2 offset:1024
    s_waitcnt lgkmcnt(0)
    v_cmp_eq_u32 vcc, 0, v7
    s_cbranch_vccz L_qgo
    s_sleep 2
    s_branch L_qwait
L_qgo:
    v_mfma_f32_16x16x32_bf16 v[28:31], v[32:35], v[8:11], 0
    v_mfma_f32_16x16x32_bf16 v[32:35], v[36:39], v[8:11], 0
    v_mfma_f32_16x16x32_bf16 v[36:39], v[64:67], v[8:11], 0
    v_mfma_f32_16x16x32_bf16 v[64:67], v[68:71], v[8:11], 0
    v_mfma_f32_16x16x32_bf16 v[68:71], v[40:43], v[8:11], 0
    v_mfma_f32_16x16x32_bf16 v[40:43], v[44:47], v[8:11], 0
    v_mfma_f32_16x16x32_bf16 v[44:47], v[72:75], v[8:11], 0
    v_mfma_f32_16x16x32_bf16 v[72:75], v[76:79], v[8:11], 0
    v_mfma_f32_16x16x32_bf16 v[76:79], v[48:51], v[8:11], 0
    v_mfma_f32_16x16x32_bf16 v[48:51], v[52:55], v[8:11], 0
    v_mfma_f32_16x16x32_bf16 v[52:55], v[80:83], v[8:11], 0
    v_mfma_f32_16x16x32_bf16 v[80:83], v[84:87], v[8:11], 0
    v_mfma_f32_16x16x32_bf16 v[84:87], v[56:59], v[8:11], 0
    v_mfma_f32_16x16x32_bf16 v[56:59], v[60:63], v[8:11], 0
    v_mfma_f32_16x16x32_bf16 v[60:63], v[88:91], v[8:11], 0
    v_mfma_f32_16x16x32_bf16 v[88:91], v[92:95], v[8:11], 0
    v_add_f32_dpp v12, v29, v28 row_ror:12 row_mask:0xf bank_mask:0x1
    v_add_f32_dpp v13, v33, v32 row_ror:12 row_mask:0xf bank_mask:0x1
    v_add_f32_dpp v14, v37, v36 row_ror:12 row_mask:0xf bank_mask:0x1
    v_add_f32_dpp v15, v65, v64 row_ror:12 row_mask:0xf bank_mask:0x1
    v_add_f32_dpp v12, v30, v12 row_ror:8 row_mask:0xf bank_mask:0x1
    v_add_f32_dpp v13, v34, v13 row_ror:8 row_mask:0xf bank_mask:0x1
    v_add_f32_dpp v14, v38, v14 row_ror:8 row_mask:0xf bank_mask:0x1
    v_add_f32_dpp v15, v66, v15 row_ror:8 row_mask:0xf bank_mask:0x1
    v_add_f32_dpp v12, v31, v12 row_ror:4 row_mask:0xf bank_mask:0x1
    v_add_f32_dpp v13, v35, v13 row_ror:4 row_mask:0xf bank_mask:0x1
    v_add_f32_dpp v14, v39, v14 row_ror:4 row_mask:0xf bank_mask:0x1
    v_add_f32_dpp v15, v67, v15 row_ror:4 row_mask:0xf bank_mask:0x1
    v_add_f32_dpp v12, v70, v69 row_ror:12 row_mask:0xf bank_mask:0x2
    v_add_f32_dpp v13, v42, v41 row_ror:12 row_mask:0xf bank_mask:0x2
    v_add_f32_dpp v14, v46, v45 row_ror:12 row_mask:0xf bank_mask:0x2
    v_add_f32_dpp v15, v74, v73 row_ror:12 row_mask:0xf bank_mask:0x2
    v_add_f32_dpp v12, v71, v12 row_ror:8 row_mask:0xf bank_mask:0x2
    v_add_f32_dpp v13, v43, v13 row_ror:8 row_mask:0xf bank_mask:0x2
    v_add_f32_dpp v14, v47, v14 row_ror:8 row_mask:0xf bank_mask:0x2
    v_add_f32_dpp v15, v75, v15 row_ror:8 row_mask:0xf bank_mask:0x2
    v_add_f32_dpp v12, v68, v12 row_ror:4 row_mask:0xf bank_mask:0x2
    v_add_f32_dpp v13, v40, v13 row_ror:4 row_mask:0xf bank_mask:0x2
    v_add_f32_dpp v14, v44, v14 row_ror:4 row_mask:0xf bank_mask:0x2
    v_add_f32_dpp v15, v72, v15 row_ror:4 row_mask:0xf bank_mask:0x2
    v_add_f32_dpp v12, v79, v78 row_ror:12 row_mask:0xf bank_mask:0x4
    v_add_f32_dpp v13, v51, v50 row_ror:12 row_mask:0xf bank_mask:0x4
    v_add_f32_dpp v14, v55, v54 row_ror:12 row_mask:0xf bank_mask:0x4
    v_add_f32_dpp v15, v83, v82 row_ror:12 row_mask:0xf bank_mask:0x4
    v_add_f32_dpp v12, v76, v12 row_ror:8 row_mask:0xf bank_mask:0x4
    v_add_f32_dpp v13, v48, v13 row_ror:8 row_mask:0xf bank_mask:0x4
    v_add_f32_dpp v14, v52, v14 row_ror:8 row_mask:0xf bank_mask:0x4
    v_add_f32_dpp v15, v80, v15 row_ror:8 row_mask:0xf bank_mask:0x4
    v_add_f32_dpp v12, v77, v12 row_ror:4 row_mask:0xf bank_mask:0x4
    v_add_f32_dpp v13, v49, v13 row_ror:4 row_mask:0xf bank_mask:0x4
    v_add_f32_dpp v14, v53, v14 row_ror:4 row_mask:0xf bank_mask:0x4
    v_add_f32_dpp v15, v81, v15 row_ror:4 row_mask:0xf bank_mask:0x4
    v_add_f32_dpp v12, v84, v87 row_ror:12 row_mask:0xf bank_mask:0x8
    v_add_f32_dpp v13, v56, v59 row_ror:12 row_mask:0xf bank_mask:0x8
    v_add_f32_dpp v14, v60, v63 row_ror:12 row_mask:0xf bank_mask:0x8
    v_add_f32_dpp v15, v88, v91 row_ror:12 row_mask:0xf bank_mask:0x8
    v_add_f32_dpp v12, v85, v12 row_ror:8 row_mask:0xf bank_mask:0x8
    v_add_f32_dpp v13, v57, v13 row_ror:8 row_mask:0xf bank_mask:0x8
    v_add_f32_dpp v14, v61, v14 row_ror:8 row_mask:0xf bank_mask:0x8
    v_add_f32_dpp v15, v89, v15 row_ror:8 row_mask:0xf bank_mask:0x8
    v_add_f32_dpp v12, v86, v12 row_ror:4 row_mask:0xf bank_mask:0x8
    v_add_f32_dpp v13, v58, v13 row_ror:4 row_mask:0xf bank_mask:0x8
    v_add_f32_dpp v14, v62, v14 row_ror:4 row_mask:0xf bank_mask:0x8
    v_add_f32_dpp v15, v90, v15 row_ror:4 row_mask:0xf bank_mask:0x8
    v_cvt_pk_bf16_f32 v1, v12, v13
    v_cvt_pk_bf16_f32 v3, v14, v15
    v_lshlrev_b32 v12, 16, v1
    v_and_b32 v13, 0xffff0000, v1
    v_lshlrev_b32 v14, 16, v3
    v_and_b32 v15, 0xffff0000, v3
    v_mul_f32 v12, 0x3db504f3, v12
    v_mul_f32 v13, 0x3db504f3, v13
    v_mul_f32 v14, 0x3db504f3, v14
    v_mul_f32 v15, 0x3db504f3, v15
    v_cvt_pk_bf16_f32 v1, v12, v13
    v_cvt_pk_bf16_f32 v3, v14, v15
    v_lshlrev_b32 v12, 16, v1
    v_and_b32 v13, 0xffff0000, v1
    v_lshlrev_b32 v14, 16, v3
    v_and_b32 v15, 0xffff0000, v3
    v_max3_f32 v1, v12, v13, v14
    v_max_f32 v1, v1, v15
    s_nop 1
    v_max_f32_dpp v1, v1, v1 row_ror:4 row_mask:0xf bank_mask:0xf
    s_nop 1
    v_max_f32_dpp v1, v1, v1 row_ror:8 row_mask:0xf bank_mask:0xf
    s_nop 0
    v_mov_b32 v3, v1
    s_nop 1
    v_permlane16_swap_b32 v1, v3
    s_nop 0
    v_max_f32 v1, v1, v3
    v_mov_b32 v3, v1
    s_nop 1
    v_permlane32_swap_b32 v1, v3
    s_nop 0
    v_max_f32 v1, v1, v3
    v_mul_f32 v28, s25, v1
    v_fma_f32 v12, v12, s25, -v28
    v_fma_f32 v13, v13, s25, -v28
    v_fma_f32 v14, v14, s25, -v28
    v_fma_f32 v15, v15, s25, -v28
    v_exp_f32 v12, v12
    v_exp_f32 v13, v13
    v_exp_f32 v14, v14
    v_exp_f32 v15, v15
    v_add_f32 v29, v12, v13
    v_cvt_pk_bf16_f32 v4, v12, v13
    v_add_f32 v1, v14, v15
    v_cvt_pk_bf16_f32 v5, v14, v15
    v_add_f32 v29, v29, v1
    v_mov_b32 v30, 1
    s_nop 0
    v_add_f32_dpp v29, v29, v29 row_ror:4 row_mask:0xf bank_mask:0xf
    s_nop 1
    v_add_f32_dpp v29, v29, v29 row_ror:8 row_mask:0xf bank_mask:0xf
    s_nop 0
    v_mov_b32 v3, v29
    s_nop 1
    v_permlane16_swap_b32 v29, v3
    s_nop 0
    v_add_f32 v29, v29, v3
    v_mov_b32 v3, v29
    s_nop 1
    v_permlane32_swap_b32 v29, v3
    s_lshl_b32 s28, s24, 6
    v_add_f32 v29, v29, v3
    v_and_b32 v1, 3, v0
    v_lshl_add_u32 v1, v1, 4, s28
    ds_write_b96 v1, v[28:30] offset:256
    v_and_b32 v32, v4, v16
    v_and_b32_dpp v33, v4, v16 row_ror:12 row_mask:0xf bank_mask:0xf
    v_and_b32_dpp v34, v4, v16 row_ror:8 row_mask:0xf bank_mask:0xf
    v_and_b32_dpp v35, v4, v16 row_ror:4 row_mask:0xf bank_mask:0xf
    v_and_b32_dpp v36, v4, v17 row_ror:4 row_mask:0xf bank_mask:0xf
    v_and_b32 v37, v4, v17
    v_and_b32_dpp v38, v4, v17 row_ror:12 row_mask:0xf bank_mask:0xf
    v_and_b32_dpp v39, v4, v17 row_ror:8 row_mask:0xf bank_mask:0xf
    v_and_b32_dpp v40, v4, v18 row_ror:8 row_mask:0xf bank_mask:0xf
    v_and_b32_dpp v41, v4, v18 row_ror:4 row_mask:0xf bank_mask:0xf
    v_and_b32 v42, v4, v18
    v_and_b32_dpp v43, v4, v18 row_ror:12 row_mask:0xf bank_mask:0xf
    v_and_b32_dpp v44, v4, v19 row_ror:12 row_mask:0xf bank_mask:0xf
    v_and_b32_dpp v45, v4, v19 row_ror:8 row_mask:0xf bank_mask:0xf
    v_and_b32_dpp v46, v4, v19 row_ror:4 row_mask:0xf bank_mask:0xf
    v_and_b32 v47, v4, v19
    v_and_b32 v48, v5, v16
    v_and_b32_dpp v49, v5, v16 row_ror:12 row_mask:0xf bank_mask:0xf
    v_and_b32_dpp v50, v5, v16 row_ror:8 row_mask:0xf bank_mask:0xf
    v_and_b32_dpp v51, v5, v16 row_ror:4 row_mask:0xf bank_mask:0xf
    v_and_b32_dpp v52, v5, v17 row_ror:4 row_mask:0xf bank_mask:0xf
    v_and_b32 v53, v5, v17
    v_and_b32_dpp v54, v5, v17 row_ror:12 row_mask:0xf bank_mask:0xf
    v_and_b32_dpp v55, v5, v17 row_ror:8 row_mask:0xf bank_mask:0xf
    v_and_b32_dpp v56, v5, v18 row_ror:8 row_mask:0xf bank_mask:0xf
    v_and_b32_dpp v57, v5, v18 row_ror:4 row_mask:0xf bank_mask:0xf
    v_and_b32 v58, v5, v18
    v_and_b32_dpp v59, v5, v18 row_ror:12 row_mask:0xf bank_mask:0xf
    v_and_b32_dpp v60, v5, v19 row_ror:12 row_mask:0xf bank_mask:0xf
    v_and_b32_dpp v61, v5, v19 row_ror:8 row_mask:0xf bank_mask:0xf
    v_and_b32_dpp v62, v5, v19 row_ror:4 row_mask:0xf bank_mask:0xf
    v_and_b32 v63, v5, v19
    s_lshl_b32 s28, s24, 11
    v_lshl_add_u32 v1, v0, 4, s28
    s_lshl_b32 s28, s24, 2
    v_mov_b32 v2, s28
    s_cmp_le_u32 s3, 4
    s_cbranch_scc1 L_pv
L_vwaitb:
    ds_read_b32 v7, v6
    s_waitcnt lgkmcnt(0)
    v_cmp_gt_u32 vcc, s29, v7
    s_cbranch_vccz L_vgob
    s_sleep 1
    s_branch L_vwaitb
L_vgob:
    v_add_u32 v7, 1, v7
    global_load_dwordx4 v[96:99], v160, s[8:9] offset:0 nt
    global_load_dwordx4 v[100:103], v160, s[8:9] offset:1024 nt
    s_nop 0
    global_load_dwordx4 v[104:107], v160, s[8:9] offset:2048 nt
    global_load_dwordx4 v[108:111], v160, s[8:9] offset:3072 nt
    s_nop 0
    global_load_dwordx4 v[112:115], v161, s[8:9] offset:0 nt
    global_load_dwordx4 v[116:119], v161, s[8:9] offset:1024 nt
    s_nop 0
    global_load_dwordx4 v[120:123], v161, s[8:9] offset:2048 nt
    global_load_dwordx4 v[124:127], v161, s[8:9] offset:3072 nt
    s_nop 0
    global_load_dwordx4 v[128:131], v162, s[8:9] offset:0 nt
    global_load_dwordx4 v[132:135], v162, s[8:9] offset:1024 nt
    s_nop 0
    global_load_dwordx4 v[136:139], v162, s[8:9] offset:2048 nt
    global_load_dwordx4 v[140:143], v162, s[8:9] offset:3072 nt
    s_nop 0
    global_load_dwordx4 v[144:147], v163, s[8:9] offset:0 nt
    global_load_dwordx4 v[148:151], v163, s[8:9] offset:1024 nt
    s_nop 0
    global_load_dwordx4 v[152:155], v163, s[8:9] offset:2048 nt
    global_load_dwordx4 v[156:159], v163, s[8:9] offset:3072 nt
    ds_write_b32 v6, v7
L_pv:
    s_setprio 2
    s_lshl_b32 s28, s20, 5
    s_add_u32 s28, s28, s21
    s_lshl_b32 s28, s28, 10
    s_add_u32 s28, s28, 262144
    v_lshl_add_u32 v4, v0, 4, s28
    s_waitcnt vmcnt(14)
    v_perm_b32 v64, v100, v96, s26
    v_perm_b32 v68, v100, v96, s27
    v_perm_b32 v72, v101, v97, s26
    v_perm_b32 v76, v101, v97, s27
    v_perm_b32 v80, v102, v98, s26
    v_perm_b32 v84, v102, v98, s27
    v_perm_b32 v88, v103, v99, s26
    v_perm_b32 v92, v103, v99, s27
    s_waitcnt vmcnt(12)
    v_perm_b32 v65, v108, v104, s26
    v_perm_b32 v69, v108, v104, s27
    v_perm_b32 v73, v109, v105, s26
    v_perm_b32 v77, v109, v105, s27
    v_perm_b32 v81, v110, v106, s26
    v_perm_b32 v85, v110, v106, s27
    v_perm_b32 v89, v111, v107, s26
    v_perm_b32 v93, v111, v107, s27
    s_waitcnt vmcnt(10)
    v_perm_b32 v66, v116, v112, s26
    v_perm_b32 v70, v116, v112, s27
    v_perm_b32 v74, v117, v113, s26
    v_perm_b32 v78, v117, v113, s27
    v_perm_b32 v82, v118, v114, s26
    v_perm_b32 v86, v118, v114, s27
    v_perm_b32 v90, v119, v115, s26
    v_perm_b32 v94, v119, v115, s27
    s_waitcnt vmcnt(8)
    v_perm_b32 v67, v124, v120, s26
    v_perm_b32 v71, v124, v120, s27
    v_perm_b32 v75, v125, v121, s26
    v_mfma_f32_16x16x32_bf16 v[20:23], v[32:35], v[64:67], 0
    v_perm_b32 v79, v125, v121, s27
    v_mfma_f32_16x16x32_bf16 v[24:27], v[32:35], v[68:71], 0
    v_perm_b32 v83, v126, v122, s26
    v_mfma_f32_16x16x32_bf16 v[20:23], v[36:39], v[72:75], v[20:23]
    v_perm_b32 v87, v126, v122, s27
    v_mfma_f32_16x16x32_bf16 v[24:27], v[36:39], v[76:79], v[24:27]
    v_perm_b32 v91, v127, v123, s26
    v_mfma_f32_16x16x32_bf16 v[20:23], v[40:43], v[80:83], v[20:23]
    v_perm_b32 v95, v127, v123, s27
    v_mfma_f32_16x16x32_bf16 v[24:27], v[40:43], v[84:87], v[24:27]
    v_mfma_f32_16x16x32_bf16 v[20:23], v[44:47], v[88:91], v[20:23]
    v_mfma_f32_16x16x32_bf16 v[24:27], v[44:47], v[92:95], v[24:27]
    s_waitcnt vmcnt(6)
    v_perm_b32 v64, v132, v128, s26
    v_perm_b32 v68, v132, v128, s27
    v_perm_b32 v72, v133, v129, s26
    v_perm_b32 v76, v133, v129, s27
    v_perm_b32 v80, v134, v130, s26
    v_perm_b32 v84, v134, v130, s27
    v_perm_b32 v88, v135, v131, s26
    v_perm_b32 v92, v135, v131, s27
    ds_write_b32 v2, v30 offset:96
    s_waitcnt vmcnt(4)
    v_perm_b32 v65, v140, v136, s26
    v_perm_b32 v69, v140, v136, s27
    v_perm_b32 v73, v141, v137, s26
    v_perm_b32 v77, v141, v137, s27
    v_perm_b32 v81, v142, v138, s26
    v_perm_b32 v85, v142, v138, s27
    v_perm_b32 v89, v143, v139, s26
    v_perm_b32 v93, v143, v139, s27
    ds_read_b32 v7, v2 offset:32
    ds_read_b128 v[8:11], v1 offset:2048
    ds_read_b128 v[12:15], v1 offset:3072
    ds_read_b128 v[16:19], v6 offset:880
    ds_read_b128 v[40:43], v6 offset:864
    s_waitcnt vmcnt(2)
    v_perm_b32 v66, v148, v144, s26
    v_perm_b32 v70, v148, v144, s27
    v_perm_b32 v74, v149, v145, s26
    v_perm_b32 v78, v149, v145, s27
    v_perm_b32 v82, v150, v146, s26
    v_perm_b32 v86, v150, v146, s27
    v_perm_b32 v90, v151, v147, s26
    v_perm_b32 v94, v151, v147, s27
    s_cmp_eq_u32 s3, 8
    s_cbranch_scc1 L_w8
    s_waitcnt vmcnt(0)
    v_perm_b32 v67, v156, v152, s26
    v_perm_b32 v71, v156, v152, s27
    v_perm_b32 v75, v157, v153, s26
    v_mfma_f32_16x16x32_bf16 v[20:23], v[48:51], v[64:67], v[20:23]
    v_perm_b32 v79, v157, v153, s27
    v_mfma_f32_16x16x32_bf16 v[24:27], v[48:51], v[68:71], v[24:27]
    v_perm_b32 v83, v158, v154, s26
    v_mfma_f32_16x16x32_bf16 v[20:23], v[52:55], v[72:75], v[20:23]
    v_perm_b32 v87, v158, v154, s27
    v_mfma_f32_16x16x32_bf16 v[24:27], v[52:55], v[76:79], v[24:27]
    v_perm_b32 v91, v159, v155, s26
    v_mfma_f32_16x16x32_bf16 v[20:23], v[56:59], v[80:83], v[20:23]
    v_perm_b32 v95, v159, v155, s27
    v_mfma_f32_16x16x32_bf16 v[24:27], v[56:59], v[84:87], v[24:27]
    v_mfma_f32_16x16x32_bf16 v[20:23], v[60:63], v[88:91], v[20:23]
    v_mfma_f32_16x16x32_bf16 v[24:27], v[60:63], v[92:95], v[24:27]
    s_nop 6
    ds_write_b128 v1, v[20:23] offset:2048
    ds_write_b128 v1, v[24:27] offset:3072
    ds_write_b32 v2, v30 offset:32
    s_cmp_eq_u32 s3, 5
    s_cbranch_scc1 L_wload
    s_and_b32 s28, s3, 14
    s_cmp_eq_u32 s28, 2
    s_cbranch_scc1 L_worker
    s_endpgm
L_w8r:
    ds_read_b32 v7, v2 offset:32
    ds_read_b128 v[8:11], v1 offset:2048
    ds_read_b128 v[12:15], v1 offset:3072
    ds_read_b128 v[16:19], v6 offset:880
    ds_read_b128 v[40:43], v6 offset:864
L_w8:
    s_waitcnt lgkmcnt(0)
    v_cmp_eq_u32 vcc, 0, v7
    s_cbranch_vccnz L_w8r
    s_waitcnt vmcnt(0)
    ds_write_b32 v6, v30 offset:84
    ds_read_b32 v5, v2 offset:28
    ds_read_b128 v[32:35], v1 offset:0
    ds_read_b128 v[36:39], v1 offset:1024
    v_perm_b32 v67, v156, v152, s26
    v_perm_b32 v71, v156, v152, s27
    v_perm_b32 v75, v157, v153, s26
    v_mfma_f32_16x16x32_bf16 v[20:23], v[48:51], v[64:67], v[20:23]
    v_perm_b32 v79, v157, v153, s27
    v_mfma_f32_16x16x32_bf16 v[24:27], v[48:51], v[68:71], v[24:27]
    v_perm_b32 v83, v158, v154, s26
    v_mfma_f32_16x16x32_bf16 v[20:23], v[52:55], v[72:75], v[20:23]
    v_perm_b32 v87, v158, v154, s27
    v_mfma_f32_16x16x32_bf16 v[24:27], v[52:55], v[76:79], v[24:27]
    v_perm_b32 v91, v159, v155, s26
    v_mfma_f32_16x16x32_bf16 v[20:23], v[56:59], v[80:83], v[20:23]
    v_perm_b32 v95, v159, v155, s27
    v_mfma_f32_16x16x32_bf16 v[24:27], v[56:59], v[84:87], v[24:27]
    v_mfma_f32_16x16x32_bf16 v[20:23], v[60:63], v[88:91], v[20:23]
    v_mfma_f32_16x16x32_bf16 v[24:27], v[60:63], v[92:95], v[24:27]
    s_waitcnt lgkmcnt(0)
    v_cmp_eq_u32 vcc, 0, v5
    s_cbranch_vccz L_have7
L_spin7:
    ds_read_b32 v5, v2 offset:28
    ds_read_b128 v[32:35], v1 offset:0
    ds_read_b128 v[36:39], v1 offset:1024
    s_waitcnt lgkmcnt(0)
    v_cmp_eq_u32 vcc, 0, v5
    s_cbranch_vccnz L_spin7
L_have7:
    v_fmac_f32 v8, v32, v40
    v_fmac_f32 v9, v33, v41
    v_fmac_f32 v10, v34, v42
    v_fmac_f32 v11, v35, v43
    v_fmac_f32 v12, v36, v40
    v_fmac_f32 v13, v37, v41
    v_fmac_f32 v14, v38, v42
    v_fmac_f32 v15, v39, v43
    v_fmac_f32 v8, v20, v16
    v_fmac_f32 v9, v21, v17
    v_fmac_f32 v10, v22, v18
    v_fmac_f32 v11, v23, v19
    v_fmac_f32 v12, v24, v16
    v_fmac_f32 v13, v25, v17
    v_fmac_f32 v14, v26, v18
    v_fmac_f32 v15, v27, v19
    v_cvt_pk_bf16_f32 v8, v8, v12
    v_cvt_pk_bf16_f32 v10, v10, v14
    v_cvt_pk_bf16_f32 v9, v9, v13
    v_cvt_pk_bf16_f32 v11, v11, v15
    s_nop 0
    v_permlane32_swap_b32 v8, v10
    v_permlane32_swap_b32 v9, v11
    s_nop 1
    v_permlane16_swap_b32 v8, v9
    v_permlane16_swap_b32 v10, v11
    s_nop 0
    v_min_u32 v8, -2, v8
    global_store_dwordx4 v4, v[8:11], s[18:19] sc1
    s_endpgm
L_stubA:
    s_branch L_stubB
    .p2align 6
L_comm2:
    s_getreg_b32 s28, hwreg(HW_REG_XCC_ID, 0, 4)
    s_lshl_b32 s29, s20, 5
    s_add_u32 s27, s29, s21
    v_lshlrev_b32 v1, 4, v0
    s_lshl_b32 s25, s27, 7
    v_mov_b32 v29, s28
    s_lshl_b32 s26, s20, 12
    s_lshl_b32 s36, s21, 2
    s_add_u32 s26, s26, s36
    s_add_u32 s26, s26, 65536
    v_mov_b32 v18, s26
    s_lshl_b32 s26, s20, 12
    s_add_u32 s26, s26, 196608
    v_and_b32 v104, 31, v0
    v_lshl_add_u32 v104, v104, 7, s26
    s_add_u32 s25, s25, 131072
    v_add_u32 v16, s25, v1
    s_xor_b32 s25, s25, 128
    s_add_u32 s34, s18, s25
    s_addc_u32 s35, s19, 0
    v_and_b32 v8, 2, v2
    v_xor_b32 v8, v8, v3
    v_lshlrev_b32 v8, 4, v8
    v_lshl_add_u32 v8, v2, 7, v8
    v_xor_b32 v9, 64, v8
    v_lshrrev_b32 v2, 4, v0
    v_lshlrev_b32 v2, 10, v2
    v_bfe_u32 v3, v0, 2, 2
    v_lshl_add_u32 v2, v3, 7, v2
    v_and_b32 v3, 3, v0
    v_lshl_add_u32 v2, v3, 3, v2
    v_bfe_u32 v3, v0, 3, 2
    v_lshl_add_u32 v2, v3, 5, v2
    v_add_u32 v20, 18432, v2
    v_xor_b32 v21, 32, v20
    v_xor_b32 v22, 64, v20
    v_xor_b32 v23, 96, v20
    s_lshl_b32 s25, s20, 17
    s_lshr_b32 s26, s21, 2
    s_lshl_b32 s26, s26, 12
    s_add_u32 s25, s25, s26
    s_and_b32 s26, s21, 3
    s_lshl_b32 s26, s26, 8
    s_add_u32 s25, s25, s26
    s_add_u32 s25, s25, 1048576
    v_lshlrev_b32 v12, 15, v7
    v_lshl_add_u32 v12, v6, 4, v12
    v_add_u32 v12, s25, v12
    s_lshl_b32 s25, s20, 17
    s_lshl_b32 s26, s22, 15
    s_add_u32 s25, s25, s26
    s_bfe_u32 s26, s21, 0x20001
    s_lshl_b32 s26, s26, 10
    s_add_u32 s25, s25, s26
    s_add_u32 s25, s25, 1052672
    v_add_u32 v100, s25, v1
    v_add_u32 v101, 0x2000, v100
    v_add_u32 v102, 0x4000, v100
    v_add_u32 v103, 0x6000, v100
    s_waitcnt lgkmcnt(0)
    s_add_u32 s30, s30, 0x01010101
    s_mov_b32 s31, 0xffffff00
    v_mov_b32 v28, s30
    v_and_b32 v24, 0xff, v28
    v_bfe_u32 v25, v28, 8, 8
    v_bfe_u32 v26, v28, 16, 8
    v_lshrrev_b32 v27, 24, v28
    s_waitcnt vmcnt(4)
    ds_write_b128 v8, v[32:35] offset:18432
    ds_write_b128 v9, v[36:39] offset:19456
    ds_write_b128 v8, v[40:43] offset:20480
    ds_write_b128 v9, v[44:47] offset:21504
    ds_write_b128 v8, v[48:51] offset:22528
    ds_write_b128 v9, v[52:55] offset:23552
    ds_write_b128 v8, v[56:59] offset:24576
    ds_write_b128 v9, v[60:63] offset:25600
    ds_write_b128 v8, v[64:67] offset:26624
    ds_write_b128 v9, v[68:71] offset:27648
    ds_write_b128 v8, v[72:75] offset:28672
    ds_write_b128 v9, v[76:79] offset:29696
    ds_write_b128 v8, v[80:83] offset:30720
    ds_write_b128 v9, v[84:87] offset:31744
    ds_write_b128 v8, v[88:91] offset:32768
    ds_write_b128 v9, v[92:95] offset:33792
    s_waitcnt lgkmcnt(0)
    ds_read_b64_tr_b16 v[32:33], v20 offset:0
    ds_read_b64_tr_b16 v[34:35], v20 offset:512
    ds_read_b64_tr_b16 v[36:37], v20 offset:4096
    ds_read_b64_tr_b16 v[38:39], v20 offset:4608
    ds_read_b64_tr_b16 v[40:41], v20 offset:8192
    ds_read_b64_tr_b16 v[42:43], v20 offset:8704
    ds_read_b64_tr_b16 v[44:45], v20 offset:12288
    ds_read_b64_tr_b16 v[46:47], v20 offset:12800
    ds_read_b64_tr_b16 v[48:49], v21 offset:0
    ds_read_b64_tr_b16 v[50:51], v21 offset:512
    ds_read_b64_tr_b16 v[52:53], v21 offset:4096
    ds_read_b64_tr_b16 v[54:55], v21 offset:4608
    ds_read_b64_tr_b16 v[56:57], v21 offset:8192
    ds_read_b64_tr_b16 v[58:59], v21 offset:8704
    ds_read_b64_tr_b16 v[60:61], v21 offset:12288
    ds_read_b64_tr_b16 v[62:63], v21 offset:12800
    ds_read_b64_tr_b16 v[64:65], v22 offset:0
    ds_read_b64_tr_b16 v[66:67], v22 offset:512
    ds_read_b64_tr_b16 v[68:69], v22 offset:4096
    ds_read_b64_tr_b16 v[70:71], v22 offset:4608
    ds_read_b64_tr_b16 v[72:73], v22 offset:8192
    ds_read_b64_tr_b16 v[74:75], v22 offset:8704
    ds_read_b64_tr_b16 v[76:77], v22 offset:12288
    ds_read_b64_tr_b16 v[78:79], v22 offset:12800
    ds_read_b64_tr_b16 v[80:81], v23 offset:0
    ds_read_b64_tr_b16 v[82:83], v23 offset:512
    ds_read_b64_tr_b16 v[84:85], v23 offset:4096
    ds_read_b64_tr_b16 v[86:87], v23 offset:4608
    ds_read_b64_tr_b16 v[88:89], v23 offset:8192
    ds_read_b64_tr_b16 v[90:91], v23 offset:8704
    ds_read_b64_tr_b16 v[92:93], v23 offset:12288
    ds_read_b64_tr_b16 v[94:95], v23 offset:12800
    s_waitcnt vmcnt(0) lgkmcnt(0)
    s_mov_b32 s33, 1048576
    v_mfma_f32_16x16x32_bf16 v[132:135], v[116:119], v[32:35], 0
    v_mfma_f32_16x16x32_bf16 v[132:135], v[120:123], v[36:39], v[132:135]
    v_mfma_f32_16x16x32_bf16 v[132:135], v[124:127], v[40:43], v[132:135]
    v_mfma_f32_16x16x32_bf16 v[132:135], v[128:131], v[44:47], v[132:135]
    v_mfma_f32_16x16x32_bf16 v[136:139], v[116:119], v[48:51], 0
    v_mfma_f32_16x16x32_bf16 v[136:139], v[120:123], v[52:55], v[136:139]
    v_mfma_f32_16x16x32_bf16 v[136:139], v[124:127], v[56:59], v[136:139]
    v_mfma_f32_16x16x32_bf16 v[136:139], v[128:131], v[60:63], v[136:139]
    v_mfma_f32_16x16x32_bf16 v[140:143], v[116:119], v[64:67], 0
    v_mfma_f32_16x16x32_bf16 v[140:143], v[120:123], v[68:71], v[140:143]
    v_mfma_f32_16x16x32_bf16 v[140:143], v[124:127], v[72:75], v[140:143]
    v_mfma_f32_16x16x32_bf16 v[140:143], v[128:131], v[76:79], v[140:143]
    v_mfma_f32_16x16x32_bf16 v[144:147], v[116:119], v[80:83], 0
    v_mfma_f32_16x16x32_bf16 v[144:147], v[120:123], v[84:87], v[144:147]
    v_mfma_f32_16x16x32_bf16 v[144:147], v[124:127], v[88:91], v[144:147]
    v_mfma_f32_16x16x32_bf16 v[144:147], v[128:131], v[92:95], v[144:147]
    s_nop 7
    v_and_or_b32 v148, v132, s31, v24
    v_and_or_b32 v149, v136, s31, v25
    v_and_or_b32 v150, v140, s31, v26
    v_and_or_b32 v151, v144, s31, v27
    v_and_or_b32 v152, v133, s31, v24
    v_and_or_b32 v153, v137, s31, v25
    v_and_or_b32 v154, v141, s31, v26
    v_and_or_b32 v155, v145, s31, v27
    v_and_or_b32 v156, v134, s31, v24
    v_and_or_b32 v157, v138, s31, v25
    v_and_or_b32 v158, v142, s31, v26
    v_and_or_b32 v159, v146, s31, v27
    v_and_or_b32 v160, v135, s31, v24
    v_and_or_b32 v161, v139, s31, v25
    v_and_or_b32 v162, v143, s31, v26
    v_and_or_b32 v163, v147, s31, v27
    global_store_dwordx4 v12, v[148:151], s[18:19] offset:0
    global_store_dwordx4 v12, v[152:155], s[18:19] offset:1024
    global_store_dwordx4 v12, v[156:159], s[18:19] offset:2048
    global_store_dwordx4 v12, v[160:163], s[18:19] offset:3072
    v_mov_b32 v3, 0
L_qdelay:
    s_sleep 1
    ds_read_b32 v2, v3 offset:0
    s_waitcnt lgkmcnt(0)
    v_cmp_gt_u32 vcc, 8, v2
    s_cbranch_vccnz L_qdelay
    s_mov_b32 s32, 32
L_qpoll:
    global_load_dwordx4 v[32:35], v100, s[18:19] offset:-4096 sc1 nt
    global_load_dwordx4 v[36:39], v100, s[18:19] offset:0 sc1 nt
    global_load_dwordx4 v[40:43], v101, s[18:19] offset:-4096 sc1 nt
    global_load_dwordx4 v[44:47], v101, s[18:19] offset:0 sc1 nt
    global_load_dwordx4 v[48:51], v102, s[18:19] offset:-4096 sc1 nt
    global_load_dwordx4 v[52:55], v102, s[18:19] offset:0 sc1 nt
    global_load_dwordx4 v[56:59], v103, s[18:19] offset:-4096 sc1 nt
    global_load_dwordx4 v[60:63], v103, s[18:19] offset:0 sc1 nt
    global_load_dwordx2 v[64:65], v104, s[18:19] sc1
    s_waitcnt vmcnt(0)
    v_cmp_eq_u32 s[36:37], v28, v64
    v_cmp_ne_u32 vcc, v29, v65
    s_and_b64 vcc, vcc, s[36:37]
    s_cbranch_scc0 L_qchk
    s_cmp_eq_u32 s32, 0
    s_cbranch_scc1 L_qchk
    s_mov_b32 s32, 0
    global_store_dwordx4 v12, v[148:151], s[18:19] offset:0 sc1
    global_store_dwordx4 v12, v[152:155], s[18:19] offset:1024 sc1
    global_store_dwordx4 v12, v[156:159], s[18:19] offset:2048 sc1
    global_store_dwordx4 v12, v[160:163], s[18:19] offset:3072 sc1
    s_waitcnt vmcnt(0)
L_qchk:
    v_xor_b32 v32, v24, v32
    v_xor_b32 v33, v25, v33
    v_xor_b32 v34, v26, v34
    v_xor_b32 v35, v27, v35
    v_xor_b32 v36, v24, v36
    v_xor_b32 v37, v25, v37
    v_xor_b32 v38, v26, v38
    v_xor_b32 v39, v27, v39
    v_xor_b32 v40, v24, v40
    v_xor_b32 v41, v25, v41
    v_xor_b32 v42, v26, v42
    v_xor_b32 v43, v27, v43
    v_xor_b32 v44, v24, v44
    v_xor_b32 v45, v25, v45
    v_xor_b32 v46, v26, v46
    v_xor_b32 v47, v27, v47
    v_xor_b32 v48, v24, v48
    v_xor_b32 v49, v25, v49
    v_xor_b32 v50, v26, v50
    v_xor_b32 v51, v27, v51
    v_xor_b32 v52, v24, v52
    v_xor_b32 v53, v25, v53
    v_xor_b32 v54, v26, v54
    v_xor_b32 v55, v27, v55
    v_xor_b32 v56, v24, v56
    v_xor_b32 v57, v25, v57
    v_xor_b32 v58, v26, v58
    v_xor_b32 v59, v27, v59
    v_xor_b32 v60, v24, v60
    v_xor_b32 v61, v25, v61
    v_xor_b32 v62, v26, v62
    v_xor_b32 v63, v27, v63
    v_or_b32 v2, v32, v33
    v_or3_b32 v2, v2, v34, v35
    v_or3_b32 v2, v2, v36, v37
    v_or3_b32 v2, v2, v38, v39
    v_or3_b32 v2, v2, v40, v41
    v_or3_b32 v2, v2, v42, v43
    v_or3_b32 v2, v2, v44, v45
    v_or3_b32 v2, v2, v46, v47
    v_or3_b32 v2, v2, v48, v49
    v_or3_b32 v2, v2, v50, v51
    v_or3_b32 v2, v2, v52, v53
    v_or3_b32 v2, v2, v54, v55
    v_or3_b32 v2, v2, v56, v57
    v_or3_b32 v2, v2, v58, v59
    v_or3_b32 v2, v2, v60, v61
    v_or3_b32 v2, v2, v62, v63
    v_and_b32 v2, 0xff, v2
    v_cmp_ne_u32 vcc, 0, v2
    s_sub_u32 s33, s33, 1
    s_cbranch_scc1 L_qok
    s_orn2_b64 vcc, vcc, s[36:37]
    s_cbranch_scc1 L_qpoll
L_qok:
    v_add_f32 v32, v32, v40
    v_add_f32 v48, v48, v56
    v_add_f32 v33, v33, v41
    v_add_f32 v49, v49, v57
    v_add_f32 v34, v34, v42
    v_add_f32 v50, v50, v58
    v_add_f32 v35, v35, v43
    v_add_f32 v51, v51, v59
    v_add_f32 v32, v32, v48
    v_add_f32 v33, v33, v49
    v_add_f32 v34, v34, v50
    v_add_f32 v35, v35, v51
    v_add_f32 v36, v36, v44
    v_add_f32 v52, v52, v60
    v_add_f32 v37, v37, v45
    v_add_f32 v53, v53, v61
    v_add_f32 v38, v38, v46
    v_add_f32 v54, v54, v62
    v_add_f32 v39, v39, v47
    v_add_f32 v55, v55, v63
    v_add_f32 v36, v36, v52
    v_add_f32 v37, v37, v53
    v_add_f32 v38, v38, v54
    v_add_f32 v39, v39, v55
    v_cvt_pk_bf16_f32 v32, v32, v33
    v_cvt_pk_bf16_f32 v33, v34, v35
    v_cvt_pk_bf16_f32 v34, v36, v37
    v_cvt_pk_bf16_f32 v35, v38, v39
    v_lshlrev_b32 v2, 7, v7
    v_lshl_add_u32 v2, v6, 1, v2
    v_mov_b32 v40, 1
    v_mov_b32 v41, s30
    v_mov_b32 v42, s32
    ds_write_b16 v2, v32 offset:1024
    ds_write_b16_d16_hi v2, v32 offset:1056
    ds_write_b16 v2, v33 offset:1088
    ds_write_b16_d16_hi v2, v33 offset:1120
    ds_write_b16 v2, v34 offset:1536
    ds_write_b16_d16_hi v2, v34 offset:1568
    ds_write_b16 v2, v35 offset:1600
    ds_write_b16_d16_hi v2, v35 offset:1632
    ds_write_b96 v3, v[40:42] offset:16
    s_cmp_eq_u32 s32, 32
    s_mov_b64 exec, 1
    s_cbranch_scc1 L_flg_l
    global_store_dword v18, v28, s[18:19] sc1
    s_branch L_flg_d
L_flg_l:
    global_store_dword v18, v28, s[18:19]
L_flg_d:
    s_mov_b64 exec, -1
    v_and_b32 v2, 31, v0
    v_lshlrev_b32 v6, 4, v2
    v_lshlrev_b32 v7, 2, v2
    v_and_b32 v2, 3, v0
    v_cmp_eq_u32 s[40:41], 1, v2
    v_cmp_eq_u32 s[42:43], 2, v2
    v_cmp_eq_u32 s[44:45], 3, v2
L_mlwait:
    s_sleep 2
    ds_read_b96 v[8:10], v6 offset:256
    s_waitcnt lgkmcnt(0)
    v_cmp_eq_u32 vcc, 0, v10
    s_cbranch_vccnz L_mlwait
    v_max_f32_dpp v11, v8, v8 row_ror:4 row_mask:0xf bank_mask:0xf
    s_nop 1
    v_max_f32_dpp v11, v11, v11 row_ror:8 row_mask:0xf bank_mask:0xf
    s_nop 0
    v_mov_b32 v2, v11
    s_nop 1
    v_permlane16_swap_b32 v11, v2
    s_nop 0
    v_max_f32 v11, v11, v2
    v_sub_f32 v8, v8, v11
    v_exp_f32 v8, v8
    s_nop 0
    v_mul_f32 v9, v8, v9
    s_nop 1
    v_add_f32_dpp v9, v9, v9 row_ror:4 row_mask:0xf bank_mask:0xf
    s_nop 1
    v_add_f32_dpp v9, v9, v9 row_ror:8 row_mask:0xf bank_mask:0xf
    s_nop 0
    v_mov_b32 v2, v9
    s_nop 1
    v_permlane16_swap_b32 v9, v2
    s_nop 0
    v_add_f32 v9, v9, v2
    v_log_f32 v10, v9
    s_nop 0
    v_add_f32 v10, v10, v11
    v_mov_b32 v11, v28
    s_mov_b64 exec, 0xff
    global_store_dwordx4 v16, v[10:13], s[18:19] sc1
    s_mov_b64 exec, -1
    s_mov_b32 s33, 1048576
    ds_write_b32 v7, v8 offset:768
    v_mov_b32 v20, 0
    v_mov_b32 v21, 0
    v_mov_b32 v22, 0
    v_mov_b32 v23, 0
    v_mov_b32 v24, 0
    v_mov_b32 v25, 0
    v_mov_b32 v26, 0
    v_mov_b32 v27, 0
    v_mov_b32 v14, 0
    s_mov_b32 s25, 0
    s_setprio 1
    s_mov_b32 s26, 4
    s_branch L_red
L_lsepoll:
    s_load_dwordx16 s[48:63], s[34:35], 0 glc
    s_sub_u32 s33, s33, 1
    s_cbranch_scc1 L_lseok
    s_waitcnt lgkmcnt(0)
    s_xor_b32 s49, s49, s30
    s_xor_b32 s53, s53, s30
    s_xor_b32 s57, s57, s30
    s_xor_b32 s61, s61, s30
    s_or_b32 s49, s49, s53
    s_or_b32 s57, s57, s61
    s_or_b32 s49, s49, s57
    s_cbranch_scc0 L_lseok
    s_sleep 8
    s_branch L_lsepoll
L_lseok:
    s_waitcnt lgkmcnt(0)
    v_mov_b32 v11, s48
    v_mov_b32 v2, s52
    v_cndmask_b32 v11, v11, v2, s[40:41]
    v_mov_b32 v2, s56
    v_cndmask_b32 v11, v11, v2, s[42:43]
    v_mov_b32 v2, s60
    v_cndmask_b32 v11, v11, v2, s[44:45]
    v_sub_f32 v11, v11, v10
    v_exp_f32 v11, v11
    s_nop 0
    v_fma_f32 v9, v9, v11, v9
    v_rcp_f32 v9, v9
    s_nop 0
    v_mul_f32 v8, v8, v9
    ds_write_b32 v7, v8 offset:768
    v_mul_f32_dpp v20, v9, v20 quad_perm:[0,0,0,0] row_mask:0xf bank_mask:0xf
    v_mul_f32_dpp v21, v9, v21 quad_perm:[1,1,1,1] row_mask:0xf bank_mask:0xf
    v_mul_f32_dpp v22, v9, v22 quad_perm:[2,2,2,2] row_mask:0xf bank_mask:0xf
    v_mul_f32_dpp v23, v9, v23 quad_perm:[3,3,3,3] row_mask:0xf bank_mask:0xf
    v_mul_f32_dpp v24, v9, v24 quad_perm:[0,0,0,0] row_mask:0xf bank_mask:0xf
    v_mul_f32_dpp v25, v9, v25 quad_perm:[1,1,1,1] row_mask:0xf bank_mask:0xf
    v_mul_f32_dpp v26, v9, v26 quad_perm:[2,2,2,2] row_mask:0xf bank_mask:0xf
    v_mul_f32_dpp v27, v9, v27 quad_perm:[3,3,3,3] row_mask:0xf bank_mask:0xf
    s_mov_b32 s26, 6
L_red:
    ds_read_b32 v4, v3 offset:32
    ds_read_b128 v[32:35], v1 offset:2048
    ds_read_b128 v[36:39], v1 offset:3072
    ds_read_b128 v[40:43], v14 offset:768
    s_waitcnt lgkmcnt(0)
    v_cmp_eq_u32 vcc, 0, v4
    s_cbranch_vccnz L_red
    v_fmac_f32 v20, v32, v40
    v_fmac_f32 v21, v33, v41
    v_fmac_f32 v22, v34, v42
    v_fmac_f32 v23, v35, v43
    v_fmac_f32 v24, v36, v40
    v_fmac_f32 v25, v37, v41
    v_fmac_f32 v26, v38, v42
    v_fmac_f32 v27, v39, v43
    v_add_u32 v1, 2048, v1
    v_add_u32 v14, 16, v14
    v_add_u32 v3, 4, v3
    s_add_u32 s25, s25, 1
    s_cmp_lt_u32 s25, s26
    s_cbranch_scc1 L_red
    s_cmp_eq_u32 s25, 4
    s_cbranch_scc1 L_lsepoll
L_reddone:
    ds_write_b128 v1, v[20:23] offset:4096
    ds_write_b128 v1, v[24:27] offset:5120
    ds_write_b32 v3, v4 offset:36
    s_lshl_b32 s25, s20, 2
    s_and_b32 s26, s21, 1
    s_add_u32 s25, s25, s26
    s_mul_i32 s25, s25, 256
    s_add_u32 s25, s25, 524288
    s_add_u32 s40, s18, s25
    s_addc_u32 s41, s19, 0
    s_lshr_b32 s25, s21, 1
    s_lshl_b32 s25, 1, s25
    v_mov_b32 v3, 0
L_hwait:
    ds_read_b32 v2, v3 offset:124
    s_waitcnt lgkmcnt(0)
    v_cmp_eq_u32 vcc, 0, v2
    s_cbranch_vccnz L_hwait
    s_atomic_or s25, s[40:41], 0
    s_atomic_or s25, s[40:41], 8192
    s_atomic_or s25, s[40:41], 16384
    s_atomic_or s25, s[40:41], 24576
    s_atomic_or s25, s[40:41], 32768
    s_atomic_or s25, s[40:41], 40960
    s_atomic_or s25, s[40:41], 49152
    s_atomic_or s25, s[40:41], 57344
    s_waitcnt lgkmcnt(0)
    s_endpgm
    .p2align 6
L_wload:
    s_waitcnt lgkmcnt(0)
    s_lshl_b32 s25, s21, 17
    s_xor_b32 s26, s20, 1
    s_lshl_b32 s26, s26, 7
    s_add_u32 s25, s25, s26
    v_lshrrev_b32 v8, 3, v0
    v_lshlrev_b32 v8, 10, v8
    v_lshrrev_b32 v9, 3, v0
    v_and_b32 v9, 2, v9
    v_xor_b32 v9, v9, v0
    v_and_b32 v9, 7, v9
    v_lshl_add_u32 v2, v9, 4, v8
    v_xor_b32 v3, 64, v2
    v_add_u32 v2, s25, v2
    v_add_u32 v3, s25, v3
    v_add_u32 v3, 7168, v3
L_wwait:
    ds_read_b32 v7, v6
    s_waitcnt lgkmcnt(0)
    v_cmp_gt_u32 vcc, 16, v7
    s_cbranch_vccz L_wgo
    s_sleep 1
    s_branch L_wwait
L_wgo:
L_wpf:
    ds_read_b32 v7, v6 offset:124
    s_waitcnt lgkmcnt(0)
    v_cmp_eq_u32 vcc, 0, v7
    s_cbranch_vccz L_wgo1
    s_sleep 1
    s_branch L_wpf
L_wgo1:
    s_mov_b32 m0, 34816
    s_nop 0
L_dma_wo:
    global_load_lds_dwordx4 v2, s[12:13] nt
    global_load_lds_dwordx4 v3, s[12:13] offset:1024 nt
    s_add_u32 m0, m0, 2048
    v_add_u32 v2, 16384, v2
    v_add_u32 v3, 16384, v3
    s_cmp_lt_u32 m0, 51200
    s_cbranch_scc1 L_dma_wo
    s_mov_b64 exec, 1
    s_waitcnt vmcnt(12)
    ds_add_u32 v6, v30 offset:68
    s_waitcnt vmcnt(8)
    ds_add_u32 v6, v30 offset:68
    s_waitcnt vmcnt(4)
    ds_add_u32 v6, v30 offset:68
    s_waitcnt vmcnt(0)
    ds_add_u32 v6, v30 offset:68
    s_mov_b64 exec, -1
    s_endpgm
L_worker:
    s_mov_b64 exec, 0
    s_branch L_stubA
L_backA:
    s_mov_b64 exec, -1
    s_setprio 1
    s_waitcnt lgkmcnt(0)
    ds_read_b96 v[16:18], v6 offset:16
    s_and_b32 s27, s3, 1
    v_lshrrev_b32 v8, 4, v0
    v_lshlrev_b32 v8, 10, v8
    v_bfe_u32 v9, v0, 2, 2
    v_lshl_add_u32 v8, v9, 7, v8
    v_and_b32 v9, 3, v0
    v_lshl_add_u32 v8, v9, 3, v8
    v_bfe_u32 v9, v0, 3, 2
    v_lshl_add_u32 v8, v9, 5, v8
    v_add_u32 v20, 34816, v8
    s_lshl_b32 s25, s27, 6
    v_xor_b32 v22, s25, v20
    v_xor_b32 v23, 32, v22
    v_xor_b32 v20, 64, v22
    v_xor_b32 v21, 64, v23
    v_and_b32 v8, 15, v0
    v_lshrrev_b32 v7, 4, v0
    s_lshr_b32 s22, s21, 2
    s_lshl_b32 s25, s22, 5
    s_add_u32 s25, s25, s27
    s_lshl_b32 s25, s25, 10
    s_and_b32 s26, s21, 3
    s_lshl_b32 s26, s26, 8
    s_add_u32 s25, s25, s26
    s_add_u32 s25, s25, 262144
    v_lshlrev_b32 v4, 11, v8
    v_lshl_add_u32 v4, v7, 4, v4
    v_add_u32 v4, s25, v4
    s_lshl_b32 s25, s20, 17
    s_lshl_b32 s26, s21, 7
    s_add_u32 s25, s25, s26
    s_lshl_b32 s26, s27, 16
    s_add_u32 s25, s25, s26
    s_add_u32 s25, s25, 1048576
    v_lshrrev_b32 v12, 3, v0
    v_lshlrev_b32 v12, 12, v12
    v_and_b32 v9, 7, v0
    v_lshl_add_u32 v12, v9, 4, v12
    v_add_u32 v12, s25, v12
    v_add_u32 v13, 0x8000, v12
    s_lshl_b32 s25, s22, 12
    s_add_u32 s25, s25, 196608
    v_and_b32 v5, 31, v0
    v_lshl_add_u32 v5, v5, 7, s25
    s_lshl_b32 s26, s20, 5
    s_andn2_b32 s25, s21, 3
    s_add_u32 s26, s26, s25
    s_add_u32 s26, s26, s27
    s_mul_i32 s26, s26, 256
    s_add_u32 s26, s26, 524288
    s_add_u32 s48, s18, s26
    s_addc_u32 s49, s19, 0
    s_lshl_b32 s25, s27, 11
    v_lshl_add_u32 v10, v0, 4, s25
    v_xor_b32 v11, 0x800, v10
    s_lshl_b32 s25, s27, 2
    v_mov_b32 v14, s25
    v_xor_b32 v15, 4, v14
    v_mov_b32 v96, -1
    v_mov_b32 v100, -1
    v_mov_b32 v104, -1
    v_mov_b32 v108, -1
    s_mov_b32 s34, 1048576
    s_mov_b32 s31, 0xffffff00
    s_mov_b32 s46, 0
    s_mov_b32 s50, 0
    s_mov_b32 s52, 0
    s_mov_b32 s53, 0
    s_mov_b32 s54, 0
    s_mov_b32 s47, 2000
    s_waitcnt lgkmcnt(0)
    v_readfirstlane_b32 s30, v17
    v_readfirstlane_b32 s32, v18
    v_xor_b32 v26, 0x80, v17
    v_and_b32 v26, 0xff, v26
L_wkgate:
    s_sleep 2
    ds_read_b32 v16, v6 offset:64
    s_waitcnt lgkmcnt(0)
    v_cmp_eq_u32 vcc, 0, v16
    s_cbranch_vccnz L_wkgate
L_wkgate2:
    s_sleep 1
    ds_read_b32 v16, v6 offset:84
    s_waitcnt lgkmcnt(0)
    v_cmp_eq_u32 vcc, 0, v16
    s_cbranch_vccnz L_wkgate2
    v_mov_b32 v17, 0
L_msk:
    s_load_dword s52, s[48:49], 0 glc
    ds_read_b32 v17, v6 offset:68
    s_sleep 4
    s_cmp_ge_u32 s54, 3
    s_cbranch_scc1 L_free
    s_waitcnt lgkmcnt(0)
L_free:
    s_or_b32 s53, s53, s52
    s_cmpk_eq_u32 s53, 0xffff
    s_cbranch_scc1 L_mskall
    s_andn2_b32 s45, s53, s46
    s_bcnt1_i32_b32 s44, s45
    s_cmp_lt_u32 s44, 3
    s_cbranch_scc1 L_msknone
    s_mov_b32 s46, s53
    s_pack_ll_b32_b16 exec_lo, s45, s45
    s_mov_b32 exec_hi, exec_lo
    global_load_dwordx4 v[96:99], v4, s[18:19] offset:0
    global_load_dwordx4 v[100:103], v4, s[18:19] offset:64
    global_load_dwordx4 v[104:107], v4, s[18:19] offset:128
    global_load_dwordx4 v[108:111], v4, s[18:19] offset:192
    s_mov_b64 exec, -1
L_msknone:
    s_bcnt1_i32_b32 s54, s53
    s_cbranch_scc1 L_nosl
    s_sleep 4
L_nosl:
L_nosl2:
    s_sub_u32 s47, s47, 1
    s_cbranch_scc0 L_msk
L_fallback:
    global_load_dword v16, v5, s[18:19] sc1
    s_waitcnt vmcnt(0)
    v_cmp_ne_u32 vcc, s30, v16
    s_sub_u32 s34, s34, 1
    s_cbranch_scc1 L_oaok
    s_cbranch_vccnz L_fallback
    s_mov_b32 s53, 0xffff
L_mskall:
    v_max3_u32 v18, v96, v100, v104
    v_max_u32 v18, v18, v108
    v_cmp_eq_u32 vcc, -1, v18
L_oapoll:
    s_mov_b64 exec, vcc
    s_cbranch_execz L_oa2
    global_load_dwordx4 v[96:99], v4, s[18:19] offset:0 sc1
    global_load_dwordx4 v[100:103], v4, s[18:19] offset:64 sc1
    global_load_dwordx4 v[104:107], v4, s[18:19] offset:128 sc1
    global_load_dwordx4 v[108:111], v4, s[18:19] offset:192 sc1
L_oa2:
    s_mov_b64 exec, -1
    s_cmp_lg_u32 s50, 0
    s_cbranch_scc1 L_oachk
    s_mov_b32 s50, 1
    s_branch L_wc0
L_wq0:
    ds_read_b32 v17, v6 offset:68
    s_waitcnt lgkmcnt(0)
L_wc0:
    v_cmp_gt_u32 vcc, 1, v17
    s_cbranch_vccnz L_wq0
    ds_read_b64_tr_b16 v[32:33], v20 offset:0
    ds_read_b64_tr_b16 v[34:35], v20 offset:512
    ds_read_b64_tr_b16 v[48:49], v21 offset:0
    ds_read_b64_tr_b16 v[50:51], v21 offset:512
    ds_read_b64_tr_b16 v[64:65], v22 offset:0
    ds_read_b64_tr_b16 v[66:67], v22 offset:512
    ds_read_b64_tr_b16 v[80:81], v23 offset:0
    ds_read_b64_tr_b16 v[82:83], v23 offset:512
    s_branch L_wc1
L_wq1:
    ds_read_b32 v17, v6 offset:68
    s_waitcnt lgkmcnt(0)
L_wc1:
    v_cmp_gt_u32 vcc, 2, v17
    s_cbranch_vccnz L_wq1
    ds_read_b64_tr_b16 v[36:37], v20 offset:4096
    ds_read_b64_tr_b16 v[38:39], v20 offset:4608
    ds_read_b64_tr_b16 v[52:53], v21 offset:4096
    ds_read_b64_tr_b16 v[54:55], v21 offset:4608
    ds_read_b64_tr_b16 v[68:69], v22 offset:4096
    ds_read_b64_tr_b16 v[70:71], v22 offset:4608
    ds_read_b64_tr_b16 v[84:85], v23 offset:4096
    ds_read_b64_tr_b16 v[86:87], v23 offset:4608
    s_branch L_wc2
L_wq2:
    ds_read_b32 v17, v6 offset:68
    s_waitcnt lgkmcnt(0)
L_wc2:
    v_cmp_gt_u32 vcc, 3, v17
    s_cbranch_vccnz L_wq2
    ds_read_b64_tr_b16 v[40:41], v20 offset:8192
    ds_read_b64_tr_b16 v[42:43], v20 offset:8704
    ds_read_b64_tr_b16 v[56:57], v21 offset:8192
    ds_read_b64_tr_b16 v[58:59], v21 offset:8704
    ds_read_b64_tr_b16 v[72:73], v22 offset:8192
    ds_read_b64_tr_b16 v[74:75], v22 offset:8704
    ds_read_b64_tr_b16 v[88:89], v23 offset:8192
    ds_read_b64_tr_b16 v[90:91], v23 offset:8704
    s_branch L_wc3
L_wq3:
    ds_read_b32 v17, v6 offset:68
    s_waitcnt lgkmcnt(0)
L_wc3:
    v_cmp_gt_u32 vcc, 4, v17
    s_cbranch_vccnz L_wq3
    ds_read_b64_tr_b16 v[44:45], v20 offset:12288
    ds_read_b64_tr_b16 v[46:47], v20 offset:12800
    ds_read_b64_tr_b16 v[60:61], v21 offset:12288
    ds_read_b64_tr_b16 v[62:63], v21 offset:12800
    ds_read_b64_tr_b16 v[76:77], v22 offset:12288
    ds_read_b64_tr_b16 v[78:79], v22 offset:12800
    ds_read_b64_tr_b16 v[92:93], v23 offset:12288
    ds_read_b64_tr_b16 v[94:95], v23 offset:12800
L_oachk:
L_stubB:
    s_cbranch_execz L_stubC
    s_sub_u32 s34, s34, 1
L_oaok:
    s_cselect_b64 s[28:29], 0, -1
    s_waitcnt vmcnt(0) lgkmcnt(0)
    v_mfma_f32_16x16x32_bf16 v[112:115], v[32:35], v[96:99], 0
    v_max3_u32 v18, v96, v100, v104
    v_mfma_f32_16x16x32_bf16 v[112:115], v[36:39], v[100:103], v[112:115]
    v_max_u32 v18, v18, v108
    v_mfma_f32_16x16x32_bf16 v[112:115], v[40:43], v[104:107], v[112:115]
    v_cmp_eq_u32 vcc, -1, v18
    v_mfma_f32_16x16x32_bf16 v[112:115], v[44:47], v[108:111], v[112:115]
    s_and_b64 vcc, vcc, s[28:29]
    s_cbranch_scc1 L_oapoll
    v_mfma_f32_16x16x32_bf16 v[116:119], v[48:51], v[96:99], 0
    v_mfma_f32_16x16x32_bf16 v[116:119], v[52:55], v[100:103], v[116:119]
    v_mfma_f32_16x16x32_bf16 v[116:119], v[56:59], v[104:107], v[116:119]
    v_mfma_f32_16x16x32_bf16 v[116:119], v[60:63], v[108:111], v[116:119]
    v_mfma_f32_16x16x32_bf16 v[120:123], v[64:67], v[96:99], 0
    ds_read_b32 v16, v15 offset:72
    ds_read_b128 v[128:131], v11 offset:18432
    v_mfma_f32_16x16x32_bf16 v[120:123], v[68:71], v[100:103], v[120:123]
    ds_read_b128 v[132:135], v11 offset:19456
    ds_write_b128 v10, v[112:115] offset:18432
    v_mfma_f32_16x16x32_bf16 v[120:123], v[72:75], v[104:107], v[120:123]
    s_nop 0
    ds_write_b128 v10, v[116:119] offset:19456
    ds_write_b32 v14, v30 offset:72
    v_mfma_f32_16x16x32_bf16 v[120:123], v[76:79], v[108:111], v[120:123]
    v_mfma_f32_16x16x32_bf16 v[124:127], v[80:83], v[96:99], 0
    v_mfma_f32_16x16x32_bf16 v[124:127], v[84:87], v[100:103], v[124:127]
    v_mfma_f32_16x16x32_bf16 v[124:127], v[88:91], v[104:107], v[124:127]
    v_mfma_f32_16x16x32_bf16 v[124:127], v[92:95], v[108:111], v[124:127]
    s_waitcnt lgkmcnt(3)
    v_cmp_eq_u32 vcc, 0, v16
    s_cbranch_vccz L_xok
L_xwait:
    ds_read_b32 v16, v15 offset:72
    ds_read_b128 v[128:131], v11 offset:18432
    ds_read_b128 v[132:135], v11 offset:19456
    s_waitcnt lgkmcnt(0)
    v_cmp_eq_u32 vcc, 0, v16
    s_cbranch_vccnz L_xwait
L_xok:
    s_nop 0
    v_pk_add_f32 v[120:121], v[120:121], v[128:129]
    v_pk_add_f32 v[122:123], v[122:123], v[130:131]
    v_and_or_b32 v120, v120, s31, v26
    global_store_dwordx4 v12, v[120:123], s[18:19]
    v_pk_add_f32 v[124:125], v[124:125], v[132:133]
    v_pk_add_f32 v[126:127], v[126:127], v[134:135]
    v_and_or_b32 v124, v124, s31, v26
    s_cmp_eq_u32 s32, 32
    global_store_dwordx4 v13, v[124:127], s[18:19]
    s_cbranch_scc1 L_wdone
    global_store_dwordx4 v12, v[120:123], s[18:19] sc1
    global_store_dwordx4 v13, v[124:127], s[18:19] sc1
L_wdone:
    s_endpgm
L_stubC:
    s_branch L_stubD
L_tail:
    s_getreg_b32 s28, hwreg(HW_REG_XCC_ID, 0, 4)
    s_lshl_b32 s25, s27, 7
    s_add_u32 s25, s25, 196608
    v_add_u32 v2, s25, v1
    v_mov_b32 v6, 0
    v_mov_b32 v29, s28
    s_waitcnt vmcnt(0) lgkmcnt(0)
    s_add_u32 s30, s30, 0x01010101
    v_mov_b32 v28, s30
    s_mov_b64 exec, 0xff
    global_store_dwordx4 v2, v[28:31], s[18:19] sc1
    s_mov_b64 exec, -1
    s_setprio 1
    v_lshrrev_b32 v7, 4, v0
    v_and_b32 v9, 7, v0
    s_lshl_b32 s25, s27, 12
    s_add_u32 s25, s25, 1048576
    v_add_u32 v10, s25, v1
    s_and_b32 s25, s21, 1
    s_lshl_b32 s25, s25, 13
    s_lshr_b32 s26, s21, 1
    s_lshl_b32 s26, s26, 3
    s_add_u32 s25, s25, s26
    s_xor_b32 s26, s20, 1
    s_lshl_b32 s26, s26, 7
    s_add_u32 s25, s25, s26
    v_lshlrev_b32 v11, 10, v9
    v_lshl_add_u32 v11, v7, 1, v11
    v_add_u32 v11, s25, v11
    s_lshl_b32 s25, s20, 12
    s_add_u32 s25, s25, 65536
    v_and_b32 v5, 31, v0
    v_lshl_add_u32 v8, v5, 2, s25
    v_xor_b32 v26, 0x80, v28
    v_and_b32 v26, 0xff, v26
    v_mov_b32 v3, 1
    s_mov_b32 s48, 0x00ff00ff
    s_mov_b32 s49, s48
    s_mov_b32 s33, 1048576
    s_mov_b32 s35, s33
    s_mov_b64 s[36:37], -1
    s_mov_b64 s[38:39], -1
    s_mov_b64 s[40:41], -1
    s_mov_b64 s[42:43], -1
L_twait0:
    s_sleep 2
    ds_read_b32 v16, v6
    s_waitcnt lgkmcnt(0)
    v_cmp_gt_u32 vcc, 13, v16
    s_cbranch_vccnz L_twait0
L_clrpoll:
    global_load_dword v16, v8, s[18:19] sc1
    s_waitcnt vmcnt(0)
    v_cmp_ne_u32 vcc, s30, v16
    s_sub_u32 s33, s33, 1
    s_cbranch_scc1 L_clrok
    s_cbranch_vccnz L_clrpoll
L_clrok:
    ds_write_b32 v6, v3 offset:64
L_obwait:
    s_sleep 1
    ds_read_b64 v[16:17], v6 offset:72
    s_waitcnt lgkmcnt(0)
    v_and_b32 v16, v16, v17
    v_cmp_eq_u32 vcc, 0, v16
    s_cbranch_vccnz L_obwait
L_obpoll:
    s_mov_b64 exec, s[36:37]
    s_cbranch_execz L_obs0
    global_load_dwordx4 v[32:35], v10, s[18:19] offset:0 sc1
L_obs0:
    s_mov_b64 exec, s[38:39]
    s_cbranch_execz L_obs1
    global_load_dwordx4 v[36:39], v10, s[18:19] offset:1024 sc1
L_obs1:
    s_mov_b64 exec, s[40:41]
    s_cbranch_execz L_obs2
    global_load_dwordx4 v[40:43], v10, s[18:19] offset:2048 sc1
L_obs2:
    s_mov_b64 exec, s[42:43]
    s_cbranch_execz L_obs3
    global_load_dwordx4 v[44:47], v10, s[18:19] offset:3072 sc1
L_obs3:
    s_mov_b64 exec, -1
    s_sub_u32 s35, s35, 1
    s_cbranch_scc1 L_obok
    s_waitcnt vmcnt(0)
    v_cmp_ne_u32_sdwa s[36:37], v32, v26 src0_sel:BYTE_0 src1_sel:DWORD
    v_cmp_ne_u32_sdwa s[38:39], v36, v26 src0_sel:BYTE_0 src1_sel:DWORD
    v_cmp_ne_u32_sdwa s[40:41], v40, v26 src0_sel:BYTE_0 src1_sel:DWORD
    v_cmp_ne_u32_sdwa s[42:43], v44, v26 src0_sel:BYTE_0 src1_sel:DWORD
    s_or_b64 s[44:45], s[36:37], s[38:39]
    s_or_b64 s[46:47], s[40:41], s[42:43]
    s_or_b64 s[44:45], s[44:45], s[46:47]
    s_cbranch_scc1 L_obpoll
L_obok:
    v_xor_b32 v32, v26, v32
    v_xor_b32 v36, v26, v36
    v_xor_b32 v40, v26, v40
    v_xor_b32 v44, v26, v44
    v_pk_add_f32 v[32:33], v[32:33], v[36:37]
    v_pk_add_f32 v[34:35], v[34:35], v[38:39]
    v_pk_add_f32 v[40:41], v[40:41], v[44:45]
    v_pk_add_f32 v[42:43], v[42:43], v[46:47]
    v_pk_add_f32 v[32:33], v[32:33], v[40:41]
    v_pk_add_f32 v[34:35], v[34:35], v[42:43]
    s_nop 1
    v_permlane32_swap_b32 v32, v34
    v_permlane32_swap_b32 v33, v35
    s_nop 0
    v_add_f32 v32, v32, v34
    v_add_f32 v33, v33, v35
    s_nop 1
    v_permlane16_swap_b32 v32, v33
    s_nop 0
    v_add_f32 v32, v32, v33
    s_nop 1
    v_add_f32_dpp v32, v32, v32 row_ror:8 row_mask:0xf bank_mask:0xf
    s_mov_b64 exec, s[48:49]
    v_cvt_pk_bf16_f32 v32, v32, v32
    global_store_short v11, v32, s[14:15]
    s_mov_b64 exec, -1
    s_cmp_lg_u32 s2, 0
    s_cbranch_scc1 L_tdone
    v_mov_b32 v1, 0
    v_mov_b32 v2, s30
    s_mov_b64 exec, 1
    global_store_dword v1, v2, s[18:19]
    s_mov_b64 exec, -1
L_tdone:
L_end:
    s_endpgm
L_stubD:
    s_branch L_backA
.section .rodata,"a"
.p2align 6
.amdhsa_kernel standalone__sliding_block_cached__sampling_kernel
  .amdhsa_next_free_vgpr 168
  .amdhsa_next_free_sgpr 96
  .amdhsa_accum_offset 168
  .amdhsa_float_denorm_mode_32 3
  .amdhsa_group_segment_fixed_size 0
  .amdhsa_kernarg_size 64
  .amdhsa_user_sgpr_count 2
  .amdhsa_user_sgpr_kernarg_segment_ptr 1
  .amdhsa_system_sgpr_workgroup_id_x 1
.end_amdhsa_kernel
```
